```python
import torch

def _softmax(x, axis=-1):
    return torch.softmax(x, dim=axis)
def _gelu(x):
    return torch.nn.functional.gelu(x, approximate="tanh")
def _silu(x):
    return torch.nn.functional.silu(x)
def _sigmoid(x):
    return torch.sigmoid(x)
def _layernorm(x, axis=-1, eps=1e-5):
    m = x.mean(dim=axis, keepdim=True)
    v = x.var(dim=axis, keepdim=True, unbiased=False)
    return (x - m) / torch.sqrt(v + eps)
def _scatter_add(tgt, idx, src, axis=0):
    return tgt.clone().index_add_(axis, idx, src)
def _segment_sum(src, seg, n):
    out = torch.zeros((n,) + src.shape[1:], dtype=src.dtype)
    return out.index_add_(0, seg, src)
def _pad(x, pw):
    flat = tuple(v for pair in reversed(pw) for v in pair)
    return torch.nn.functional.pad(x, flat)

kernel_name = 'standalone__linear_kernel_rfa__decode'

def setup_inputs():

    _w = (lambda a: (lambda t: t.to(torch.bfloat16) if t.is_floating_point() else t)(torch.as_tensor(a)))
    B, H, Sq, Sk, D, M = 2, 16, 1, 16384, 256, 16
    return {
        "q": _w((lambda *s: torch.randn(*s, dtype=torch.bfloat16) * 0.4)(B, H, Sq, D)),
        "k": _w((lambda *s: torch.randn(*s, dtype=torch.bfloat16) * 1.6)(B, H, Sk, D)),
        "v": _w((lambda *s: torch.randn(*s, dtype=torch.bfloat16) * 1.6)(B, H, Sk, D)),
        "omega": _w((lambda *s: torch.randn(*s, dtype=torch.bfloat16) * 1.6)(M, D)),
    }

def reference(q, k, v, omega):
    d = q.shape[-1]
    m = omega.shape[0]
    scale = float(d) ** -0.25
    qs = q * scale
    ks = k * scale
    q_proj = torch.einsum("bhsd,md->bhsm", qs, omega)
    k_proj = torch.einsum("bhsd,md->bhsm", ks, omega)
    q_sq = 0.5 * torch.einsum("bhsd,bhsd->bhs", qs, qs)[..., None]
    k_sq = 0.5 * torch.einsum("bhsd,bhsd->bhs", ks, ks)[..., None]
    inv_sqrt_m = float(m) ** -0.5
    phi_q = torch.exp(q_proj - q_sq) * inv_sqrt_m + 1e-6
    phi_k = torch.exp(k_proj - k_sq) * inv_sqrt_m + 1e-6
    kv = torch.einsum("bhsm,bhsd->bhmd", phi_k, v)
    z  = torch.einsum("bhsm->bhm", phi_k)
    num = torch.einsum("bhqm,bhmd->bhqd", phi_q, kv)
    den = torch.einsum("bhqm,bhm->bhq", phi_q, z)[..., None] + 1e-6
    return num / den
```

```asm
; @launch grid=(256,1,1) block=(384,1,1) lds=91136
.amdgcn_target "amdgcn-amd-amdhsa--gfx950"
.text
.globl standalone__linear_kernel_rfa__decode_kernel
.p2align 8
.type standalone__linear_kernel_rfa__decode_kernel,@function
standalone__linear_kernel_rfa__decode_kernel:
  s_load_dwordx2 s[20:21], s[0:1], 8
  v_readfirstlane_b32 s3, v0
  s_lshr_b32 s18, s2, 8
  s_cbranch_scc1 L_end
  s_and_b32 s18, s2, 31
  s_mul_i32 s18, s18, 33
  s_bfe_u32 s18, s18, 0x50001
  s_lshr_b32 s90, s2, 5
  s_lshl3_add_u32 s90, s18, s90
  s_lshl_b32 s48, s90, 20
  s_cmp_lg_u32 s3, 0
  s_cbranch_scc1 L_cons
  v_and_b32 v1, 32, v0
  v_lshlrev_b32 v4, 4, v0
  v_xor_b32 v4, v4, v1
  v_xor_b32 v5, 64, v4
  v_xor_b32 v6, 0x80, v4
  v_xor_b32 v7, 64, v6
  s_brev_b32 s22, 8
  s_lshl_b32 s23, 1, 17
  s_mov_b32 m0, 0
  s_xor_b32 s61, s48, 0x8000
  s_xor_b32 s62, s48, 0x1000
  s_xor_b32 s63, s48, 0x9000
  s_waitcnt lgkmcnt(0)
  buffer_load_dwordx4 v4, s[20:23], s48 offen offset:0 nt lds
  buffer_load_dwordx4 v5, s[20:23], s48 offen offset:1024 nt lds
  buffer_load_dwordx4 v6, s[20:23], s48 offen offset:2048 nt lds
  buffer_load_dwordx4 v7, s[20:23], s48 offen offset:3072 nt lds
  s_addk_i32 m0, 0x1000
  s_mov_b32 s51, 0
  buffer_load_dwordx4 v4, s[20:23], s61 offen offset:0 nt lds
  buffer_load_dwordx4 v5, s[20:23], s61 offen offset:1024 nt lds
  buffer_load_dwordx4 v6, s[20:23], s61 offen offset:2048 nt lds
  buffer_load_dwordx4 v7, s[20:23], s61 offen offset:3072 nt lds
  s_addk_i32 m0, 0x1000
  s_mov_b32 s52, 0
  buffer_load_dwordx4 v4, s[20:23], s62 offen offset:0 nt lds
  buffer_load_dwordx4 v5, s[20:23], s62 offen offset:1024 nt lds
  buffer_load_dwordx4 v6, s[20:23], s62 offen offset:2048 nt lds
  buffer_load_dwordx4 v7, s[20:23], s62 offen offset:3072 nt lds
  s_addk_i32 m0, 0x1000
  s_lshr_b32 s54, s63, 12
  buffer_load_dwordx4 v4, s[20:23], s63 offen offset:0 nt lds
  buffer_load_dwordx4 v5, s[20:23], s63 offen offset:1024 nt lds
  buffer_load_dwordx4 v6, s[20:23], s63 offen offset:2048 nt lds
  buffer_load_dwordx4 v7, s[20:23], s63 offen offset:3072 nt lds
  s_mov_b32 s50, 3
  s_mov_b32 s55, 7
  s_mov_b32 s56, 8
  s_mov_b32 s57, 9
  s_mov_b32 s58, 11
  s_mov_b32 s59, 27
  v_mov_b32 v9, 90624
  s_branch L_st
L_ld:
  s_cmpk_ge_u32 s50, 509
  s_cbranch_scc1 L_w
  s_cmp_lt_u32 s50, s52
  s_cbranch_scc0 L_nt
  s_waitcnt vmcnt(12)
L_nt:
  s_cmp_lt_u32 s50, s51
  s_cbranch_scc1 L_w
  s_waitcnt vmcnt(20)
  buffer_load_dwordx4 v4, s[20:23], s48 offen offset:0 nt lds
  buffer_load_dwordx4 v5, s[20:23], s48 offen offset:1024 nt lds
  s_waitcnt vmcnt(20)
  buffer_load_dwordx4 v6, s[20:23], s48 offen offset:2048 nt lds
  buffer_load_dwordx4 v7, s[20:23], s48 offen offset:3072 nt lds
  s_waitcnt lgkmcnt(0)
  s_branch L_st
L_w:
  s_waitcnt vmcnt(28) lgkmcnt(0)
  buffer_load_dwordx4 v4, s[20:23], s48 offen offset:0 nt lds
  buffer_load_dwordx4 v5, s[20:23], s48 offen offset:1024 nt lds
  buffer_load_dwordx4 v6, s[20:23], s48 offen offset:2048 nt lds
  buffer_load_dwordx4 v7, s[20:23], s48 offen offset:3072 nt lds
L_st:
  ds_read_b32 v8, v9 offset:12
  s_add_u32 s50, s50, 1
  s_ff1_i32_b32 m0, s50
  s_lshl_b32 s18, s50, 12
  s_movrels_b32 s19, s56
  s_and_b32 m0, s18, 0xffff
  s_xor_b32 s54, s54, s19
  s_lshl_b32 s48, s54, 12
  s_and_b32 s18, s50, s55
  s_cbranch_scc1 L_ld
  s_load_dwordx2 s[8:9], s[0:1], 16
  s_cmp_lt_u32 s50, 12
  s_cbranch_scc1 L_in2
  v_readfirstlane_b32 s53, v8
  s_barrier
  s_and_b32 s51, s53, 0xffff
  s_lshr_b32 s52, s53, 16
  s_and_b32 s18, s50, 0xff
  s_cbranch_scc1 L_ld
  s_mov_b64 s[20:21], s[8:9]
  s_cmpk_lg_u32 s50, 512
  s_cbranch_scc1 L_ld
  s_waitcnt vmcnt(16)
  s_barrier
  s_waitcnt vmcnt(8)
  s_barrier
  s_waitcnt vmcnt(0)
  s_barrier
  s_endpgm
L_in2:
  s_mov_b32 s60, 31
  s_movk_i32 s61, 95
  s_movk_i32 s62, 223
  s_movk_i32 s63, 255
  s_movk_i32 s64, 255
  s_mov_b32 s55, 3
  v_mov_b32 v10, 0
  ds_write_b32 v9, v10 offset:12
  s_setprio 3
  s_branch L_ld
L_cons:
  s_load_dwordx8 s[4:11], s[0:1], 0
  s_load_dwordx4 s[12:15], s[0:1], 32
  s_load_dwordx2 s[16:17], s[0:1], 48
  v_and_b32 v0, 63, v0
  s_cmpk_eq_u32 s3, 320
  s_cbranch_scc1 L_ctl
  v_and_b32 v1, 32, v0
  v_lshlrev_b32 v4, 4, v0
  v_xor_b32 v4, v4, v1
  v_xor_b32 v5, 64, v4
  v_xor_b32 v6, 0x80, v4
  v_xor_b32 v7, 64, v6
  s_lshr_b32 s3, s3, 6
  s_sub_u32 s66, s3, 1
  s_lshr_b32 s64, s90, 3
  s_mov_b32 s30, 8192
  s_mov_b32 s31, 0x20000
  s_mov_b32 s34, 16384
  s_mov_b32 s35, 0x20000
  s_lshl_b32 s19, s64, 9
  s_mov_b32 m0, 81920
  s_mov_b32 s18, 4096
  s_cmp_lg_u32 s66, 0
  s_waitcnt lgkmcnt(0)
  s_mov_b64 s[28:29], s[10:11]
  s_mov_b64 s[32:33], s[4:5]
  s_cbranch_scc1 L_noom
  buffer_load_dwordx4 v4, s[28:31], 0 offen offset:0 lds
  buffer_load_dwordx4 v5, s[28:31], 0 offen offset:1024 lds
  buffer_load_dwordx4 v6, s[28:31], 0 offen offset:2048 lds
  buffer_load_dwordx4 v7, s[28:31], 0 offen offset:3072 lds
  s_mov_b32 m0, 86016
  s_nop 0
  buffer_load_dwordx4 v4, s[28:31], s18 offen offset:0 lds
  buffer_load_dwordx4 v5, s[28:31], s18 offen offset:1024 lds
  buffer_load_dwordx4 v6, s[28:31], s18 offen offset:2048 lds
  buffer_load_dwordx4 v7, s[28:31], s18 offen offset:3072 lds
  s_mov_b32 m0, 90112
  s_bfm_b64 exec, 32, 0
  buffer_load_dwordx4 v4, s[32:35], s19 offen nt lds
  s_mov_b64 exec, -1
L_noom:
  s_lshr_b32 s65, s90, 5
  s_sub_u32 s65, s90, s65
  s_and_b32 s65, s65, 7
  s_mov_b64 s[40:41], s[16:17]
  s_mov_b32 s42, 671744
  s_mov_b32 s43, 0x20000
  s_mov_b64 s[36:37], s[12:13]
  s_mov_b32 s38, 16384
  s_mov_b32 s39, 0x20000
  s_mov_b64 s[44:45], s[14:15]
  s_mov_b32 s46, 256
  s_mov_b32 s47, 0x20000
  v_lshrrev_b32 v5, 4, v0
  v_and_b32 v1, 15, v0
  s_lshl_b32 s93, s64, 2
  v_lshlrev_b32 v57, 2, v0
  v_mov_b32 v58, 0
  v_mov_b32 v59, 90624
  s_add_u32 s67, s93, s66
  s_lshl_b32 s67, s67, 11
  s_lshl_b32 s68, s65, 8
  s_add_u32 s68, s68, s67
  s_mul_i32 s69, s64, 8448
  s_add_u32 s69, s69, 262144
  s_lshl_b32 s63, s65, 7
  s_add_u32 s63, s63, s69
  s_lshl_b32 s18, s66, 7
  s_add_u32 s19, s18, s19
  v_mov_b32 v7, 0x7ff00000
  v_lshlrev_b32 v60, 4, v0
  v_and_b32 v3, 7, v0
  v_lshlrev_b32 v54, 7, v3
  v_mov_b32 v29, v7
  v_mov_b32 v61, v7
  v_mov_b32 v56, v7
  v_mov_b32 v12, -1
  v_mov_b32 v13, 0xffff0000
  s_mov_b32 s94, 0x01010101
  s_mov_b32 s95, 0x01010101
  v_cndmask_b32 v54, v54, v7, s[94:95]
  s_cmp_lg_u32 s65, 0
  s_cbranch_scc1 L_noec
  buffer_load_dwordx4 v[128:131], v60, s[40:43], s67 offen sc1 nt
  buffer_load_dwordx4 v[132:135], v60, s[40:43], s67 offen offset:1024 sc1 nt
  buffer_load_dwordx2 v[136:137], v54, s[40:43], s69 offen offset:1024 sc1 nt
L_noec:
  s_branch L_pro
L_back:
  s_cbranch_scc1 L_ecw
  s_waitcnt vmcnt(0)
L_ecw:
  s_waitcnt vmcnt(3)
  s_cmp_eq_u32 s66, 2
  s_cbranch_scc1 L_phi
  s_barrier
  ds_read_b128 v[64:67], v24 offset:0
  ds_read_b128 v[68:71], v25 offset:0
  ds_read_b128 v[72:75], v26 offset:0
  ds_read_b128 v[76:79], v27 offset:0
  ds_read_b128 v[80:83], v24 offset:256
  ds_read_b128 v[84:87], v25 offset:256
  ds_read_b128 v[88:91], v26 offset:256
  ds_read_b128 v[92:95], v27 offset:256
  v_add_u32 v24, s49, v16
  v_add_u32 v25, s49, v17
  v_add_u32 v26, s49, v18
  v_add_u32 v27, s49, v19
  s_cmp_eq_u32 s52, 0
  s_cbranch_scc1 L_k_nb
L_k:
  s_barrier
L_k_nb:
  ds_read_b128 v[96:99], v24 offset:0
  ds_read_b128 v[100:103], v25 offset:0
  ds_read_b128 v[104:107], v26 offset:0
  ds_read_b128 v[108:111], v27 offset:0
  ds_read_b128 v[112:115], v24 offset:256
  ds_read_b128 v[116:119], v25 offset:256
  ds_read_b128 v[120:123], v26 offset:256
  ds_read_b128 v[124:127], v27 offset:256
  s_add_u32 s49, s49, 32768
  s_and_b32 s49, s49, 0xffff
  v_add_u32 v24, s49, v16
  v_add_u32 v25, s49, v17
  v_add_u32 v26, s49, v18
  v_add_u32 v27, s49, v19
  s_waitcnt lgkmcnt(7)
  v_mfma_f32_16x16x32_bf16 v[36:39], v[96:99], v[96:99], 0
  v_mfma_f32_16x16x32_bf16 v[32:35], v[64:67], v[96:99], 0
  s_waitcnt lgkmcnt(6)
  v_mfma_f32_16x16x32_bf16 v[36:39], v[100:103], v[100:103], v[36:39]
  v_mfma_f32_16x16x32_bf16 v[32:35], v[68:71], v[100:103], v[32:35]
  s_waitcnt lgkmcnt(5)
  v_mfma_f32_16x16x32_bf16 v[36:39], v[104:107], v[104:107], v[36:39]
  v_mfma_f32_16x16x32_bf16 v[32:35], v[72:75], v[104:107], v[32:35]
  s_waitcnt lgkmcnt(4)
  v_mfma_f32_16x16x32_bf16 v[36:39], v[108:111], v[108:111], v[36:39]
  v_mfma_f32_16x16x32_bf16 v[32:35], v[76:79], v[108:111], v[32:35]
  s_waitcnt lgkmcnt(3)
  v_mfma_f32_16x16x32_bf16 v[36:39], v[112:115], v[112:115], v[36:39]
  v_mfma_f32_16x16x32_bf16 v[32:35], v[80:83], v[112:115], v[32:35]
  s_waitcnt lgkmcnt(2)
  v_mfma_f32_16x16x32_bf16 v[36:39], v[116:119], v[116:119], v[36:39]
  v_mfma_f32_16x16x32_bf16 v[32:35], v[84:87], v[116:119], v[32:35]
  s_waitcnt lgkmcnt(1)
  v_mfma_f32_16x16x32_bf16 v[36:39], v[120:123], v[120:123], v[36:39]
  v_mfma_f32_16x16x32_bf16 v[32:35], v[88:91], v[120:123], v[32:35]
  s_waitcnt lgkmcnt(0)
  v_mfma_f32_16x16x32_bf16 v[36:39], v[124:127], v[124:127], v[36:39]
  v_mfma_f32_16x16x32_bf16 v[32:35], v[92:95], v[124:127], v[32:35]
  s_barrier
  ds_read_b64 v[52:53], v15 offset:32
  s_nop 7
  v_cndmask_b32 v40, 0, v36, s[54:55]
  v_cndmask_b32 v40, v40, v37, s[56:57]
  v_cndmask_b32 v40, v40, v38, s[58:59]
  v_cndmask_b32 v40, v40, v39, s[60:61]
  v_cvt_pk_bf16_f32 v40, v40, v40
  v_and_b32 v40, 0xffff0000, v40
  v_cvt_pk_bf16_f32 v42, v32, v33
  v_cvt_pk_bf16_f32 v43, v34, v35
  v_lshlrev_b32 v32, 16, v42
  v_and_b32 v33, 0xffff0000, v42
  v_lshlrev_b32 v34, 16, v43
  v_and_b32 v35, 0xffff0000, v43
  s_nop 1
  v_mfma_f32_16x16x4_f32 v[44:47], v8, v40, v[32:35]
  s_nop 9
  v_cvt_pk_bf16_f32 v42, v44, v45
  v_cvt_pk_bf16_f32 v43, v46, v47
  v_lshlrev_b32 v44, 16, v42
  v_and_b32 v45, 0xffff0000, v42
  v_lshlrev_b32 v46, 16, v43
  v_and_b32 v47, 0xffff0000, v43
  v_mul_f32 v44, s62, v44
  v_mul_f32 v45, s62, v45
  v_mul_f32 v46, s62, v46
  v_mul_f32 v47, s62, v47
  v_exp_f32 v44, v44
  v_exp_f32 v45, v45
  v_exp_f32 v46, v46
  v_exp_f32 v47, v47
  s_nop 0
  v_cvt_pk_bf16_f32 v42, v44, v45
  v_cvt_pk_bf16_f32 v43, v46, v47
  v_lshlrev_b32 v44, 16, v42
  v_and_b32 v45, 0xffff0000, v42
  v_lshlrev_b32 v46, 16, v43
  v_and_b32 v47, 0xffff0000, v43
  v_fmamk_f32 v44, v44, 0x3e800000, v9
  v_fmamk_f32 v45, v45, 0x3e800000, v9
  v_fmamk_f32 v46, v46, 0x3e800000, v9
  v_fmamk_f32 v47, v47, 0x3e800000, v9
  v_cvt_pk_bf16_f32 v48, v44, v45
  v_cvt_pk_bf16_f32 v49, v46, v47
  s_waitcnt lgkmcnt(0)
  s_sub_u32 s50, s50, 1
  v_mfma_f32_16x16x16_bf16 v[36:39], v[52:53], v[48:49], 0
  s_nop 7
  v_and_b32 v42, v12, v36
  v_add_f32 v14, v14, v36
  v_sub_f32 v40, v36, v42
  v_and_b32 v42, v13, v40
  v_sub_f32 v40, v40, v42
  ds_write_b16_d16_hi v28, v40
  v_add_u32 v28, 512, v28
  s_cmp_eq_u32 s50, s84
  s_cbranch_scc1 L_ke
L_ke_ret:
  s_cmp_lg_u32 s50, 0
  s_waitcnt lgkmcnt(0)
  s_cbranch_scc1 L_k
  v_lshl_add_u32 v28, v10, 6, v11
  v_add_u32 v28, 65536, v28
  s_lshl_b32 s18, s66, 6
  v_lshl_add_u32 v2, v1, 2, s18
  v_add_u32 v2, v2, v59
  ds_read_b128 v[144:147], v28
  ds_write_b32 v2, v14 offset:256
  s_mov_b32 s49, 0
  s_mov_b32 s50, 64
  s_cmp_eq_u32 s66, 0
  s_cselect_b32 s84, 62, 3
  v_lshlrev_b32 v1, 1, v0
  v_mov_b32 v24, v20
  v_mov_b32 v25, v21
  v_mov_b32 v26, v22
  v_mov_b32 v27, v23
  s_cmp_lg_u32 s52, 0
  s_waitcnt lgkmcnt(0)
  s_cbranch_scc1 L_v_nb
L_v:
  s_barrier
L_v_nb:
  ds_read_b64_tr_b16 v[128:129], v24
  ds_read_b64_tr_b16 v[130:131], v24 offset:8192
  ds_read_b64_tr_b16 v[132:133], v25
  ds_read_b64_tr_b16 v[134:135], v25 offset:8192
  ds_read_b64_tr_b16 v[136:137], v26
  ds_read_b64_tr_b16 v[138:139], v26 offset:8192
  ds_read_b64_tr_b16 v[140:141], v27
  ds_read_b64_tr_b16 v[142:143], v27 offset:8192
  s_add_u32 s49, s49, 16384
  s_and_b32 s49, s49, 0xffff
  v_add_u32 v28, 256, v28
  s_sub_u32 s50, s50, 1
  s_waitcnt lgkmcnt(6)
  v_mfma_f32_16x16x32_bf16 v[148:151], v[144:147], v[128:131], v[148:151]
  s_waitcnt lgkmcnt(4)
  v_mfma_f32_16x16x32_bf16 v[152:155], v[144:147], v[132:135], v[152:155]
  s_waitcnt lgkmcnt(2)
  v_mfma_f32_16x16x32_bf16 v[156:159], v[144:147], v[136:139], v[156:159]
  s_waitcnt lgkmcnt(0)
  v_mfma_f32_16x16x32_bf16 v[160:163], v[144:147], v[140:143], v[160:163]
  v_add_u32 v24, s49, v20
  v_add_u32 v25, s49, v21
  v_add_u32 v26, s49, v22
  v_add_u32 v27, s49, v23
  ds_read_b128 v[144:147], v28
  s_cmp_eq_u32 s50, s84
  s_cbranch_scc0 L_v
  s_cmp_lg_u32 s50, 1
  s_cbranch_scc1 L_ve
  s_cmp_lg_u32 s65, 0
  s_cbranch_scc1 L_last
  s_mov_b64 exec, s[24:25]
  buffer_load_dwordx4 v[64:67], v60, s[40:43], s67 offen sc1
  s_mov_b64 exec, -1
  buffer_load_dwordx4 v[68:71], v60, s[40:43], s67 offen offset:1024 sc1
L_last:
  s_barrier
  ds_read_b64_tr_b16 v[128:129], v24
  ds_read_b64_tr_b16 v[132:133], v25
  ds_read_b64_tr_b16 v[136:137], v26
  ds_read_b64_tr_b16 v[140:141], v27
  s_cmp_lg_u32 s28, 0
  s_barrier
  ds_read_b64_tr_b16 v[130:131], v24 offset:8192
  ds_read_b64_tr_b16 v[134:135], v25 offset:8192
  ds_read_b64_tr_b16 v[138:139], v26 offset:8192
  ds_read_b64_tr_b16 v[142:143], v27 offset:8192
  s_waitcnt lgkmcnt(3)
  v_mfma_f32_16x16x32_bf16 v[148:151], v[144:147], v[128:131], v[148:151]
  s_waitcnt lgkmcnt(2)
  v_mfma_f32_16x16x32_bf16 v[152:155], v[144:147], v[132:135], v[152:155]
  s_waitcnt lgkmcnt(1)
  v_mfma_f32_16x16x32_bf16 v[156:159], v[144:147], v[136:139], v[156:159]
  s_waitcnt lgkmcnt(0)
  v_mfma_f32_16x16x32_bf16 v[160:163], v[144:147], v[140:143], v[160:163]
  s_cbranch_scc1 L_other
  s_nop 0
  v_add_f32 v96, v149, v150
  v_add_f32 v96, v96, v148
  v_add_f32 v97, v153, v154
  v_add_f32 v97, v97, v152
  v_add_f32 v98, v157, v158
  v_add_f32 v98, v98, v156
  v_add_f32 v99, v161, v162
  v_bfi_b32 v96, 63, s20, v96
  v_add_f32 v99, v99, v160
  v_bfi_b32 v97, 63, s21, v97
  v_bfi_b32 v98, 63, s22, v98
  v_bfi_b32 v99, 63, s23, v99
  buffer_store_dwordx4 v[96:99], v29, s[40:43], s68 offen
  s_endpgm
L_far:
  buffer_store_dwordx4 v[96:99], v29, s[40:43], s68 offen sc1
  s_endpgm
L_other:
  s_mov_b64 exec, s[24:25]
  buffer_load_dwordx4 v[72:75], v60, s[40:43], s67 offen sc1
  s_mov_b64 exec, s[26:27]
  buffer_load_dwordx4 v[76:79], v60, s[40:43], s67 offen offset:1024 sc1
  s_mov_b64 exec, -1
  s_cmp_lg_u32 s65, 0
  v_add_f32 v96, v149, v150
  v_add_f32 v96, v96, v148
  v_add_f32 v97, v153, v154
  v_add_f32 v97, v97, v152
  v_add_f32 v98, v157, v158
  v_add_f32 v98, v98, v156
  v_add_f32 v99, v161, v162
  v_bfi_b32 v96, 63, s20, v96
  v_add_f32 v99, v99, v160
  v_bfi_b32 v97, 63, s21, v97
  v_bfi_b32 v98, 63, s22, v98
  v_bfi_b32 v99, 63, s23, v99
  s_cbranch_scc1 L_far
  s_mov_b64 exec, 0xffff
  v_pk_mov_b32 v[64:65], v[96:97], v[96:97] op_sel:[0,1]
  v_pk_mov_b32 v[66:67], v[98:99], v[98:99] op_sel:[0,1]
  v_pk_mov_b32 v[72:73], v[96:97], v[96:97] op_sel:[0,1]
  v_pk_mov_b32 v[74:75], v[98:99], v[98:99] op_sel:[0,1]
  s_mov_b64 exec, -1
L_chk:
  s_waitcnt vmcnt(2)
  v_pk_add_f32 v[104:105], v[64:65], v[68:69]
  v_pk_add_f32 v[106:107], v[66:67], v[70:71]
  v_bitop3_b32 v100, v64, v68, s20 bitop3:0x7e
  v_bitop3_b32 v101, v65, v69, s21 bitop3:0x7e
  v_permlane32_swap_b32 v104, v106
  v_permlane32_swap_b32 v105, v107
  v_pk_add_f32 v[104:105], v[104:105], v[106:107]
  v_bitop3_b32 v102, v66, v70, s22 bitop3:0x7e
  v_bitop3_b32 v103, v67, v71, s23 bitop3:0x7e
  v_permlane16_swap_b32 v104, v105
  v_or3_b32 v100, v100, v101, v102
  v_add_f32 v104, v104, v105
  v_bitop3_b32 v100, v100, v103, 63 bitop3:0xa8
  v_cvt_pk_bf16_f32 v104, 0, v104
  v_cmp_ne_u32 vcc, 0, v100
  v_mul_f32 v104, v104, v31
  v_cvt_pk_bf16_f32 v104, v104, v104
  s_cbranch_vccnz L_f1
  buffer_store_short v104, v1, s[36:39], s19 offen
  s_endpgm
L_f1:
  s_mov_b64 exec, s[24:25]
  buffer_load_dwordx4 v[64:67], v60, s[40:43], s67 offen sc1
  s_mov_b64 exec, -1
  buffer_load_dwordx4 v[68:71], v60, s[40:43], s67 offen offset:1024 sc1
  s_waitcnt vmcnt(2)
  v_pk_add_f32 v[104:105], v[72:73], v[76:77]
  v_pk_add_f32 v[106:107], v[74:75], v[78:79]
  v_bitop3_b32 v100, v72, v76, s20 bitop3:0x7e
  v_bitop3_b32 v101, v73, v77, s21 bitop3:0x7e
  v_permlane32_swap_b32 v104, v106
  v_permlane32_swap_b32 v105, v107
  v_pk_add_f32 v[104:105], v[104:105], v[106:107]
  v_bitop3_b32 v102, v74, v78, s22 bitop3:0x7e
  v_bitop3_b32 v103, v75, v79, s23 bitop3:0x7e
  v_permlane16_swap_b32 v104, v105
  v_or3_b32 v100, v100, v101, v102
  v_add_f32 v104, v104, v105
  v_bitop3_b32 v100, v100, v103, 63 bitop3:0xa8
  v_cvt_pk_bf16_f32 v104, 0, v104
  v_cmp_ne_u32 vcc, 0, v100
  v_mul_f32 v104, v104, v31
  v_cvt_pk_bf16_f32 v104, v104, v104
  s_cbranch_vccnz L_f2
  buffer_store_short v104, v1, s[36:39], s19 offen
  s_endpgm
L_f2:
  s_mov_b64 exec, s[24:25]
  buffer_load_dwordx4 v[72:75], v60, s[40:43], s67 offen sc1
  s_mov_b64 exec, -1
  buffer_load_dwordx4 v[76:79], v60, s[40:43], s67 offen offset:1024 sc1
  s_sub_u32 s53, s53, 1
  s_cbranch_scc0 L_chk
  s_endpgm
.p2align 12
L_ctl:
  s_getreg_b32 s54, hwreg(HW_REG_XCC_ID, 0, 4)
  s_mov_b32 s42, 671744
  s_mov_b32 s43, 0x20000
  s_mul_i32 s57, s54, 8448
  s_add_u32 s57, s57, 532480
  v_mul_u32_u24 v4, 256, v0
  v_add_u32 v4, 655360, v4
  s_bfm_b64 s[66:67], 34, 0
  s_bfm_b64 s[64:65], 8, 48
  s_mov_b64 exec, s[66:67]
  v_lshl_add_u32 v4, v0, 3, s57
  s_bfm_b64 exec, 2, 32
  v_subrev_u32 v4, 252, v4
  s_mov_b64 exec, -1
  v_mov_b32 v9, 90624
  v_mov_b32 v2, 0
  s_lshr_b32 s18, s2, 3
  s_cselect_b32 s69, 0, 3
  s_cselect_b32 s80, 0, 0x8000800
  s_cselect_b32 s81, 0, 0x4080800
  s_lshl_b32 s68, 1, s18
  s_movk_i32 s51, 6148
  s_add_u32 s54, s54, 48
  s_bfm_b64 s[72:73], 1, s54
  s_mov_b32 s56, 0
  s_waitcnt lgkmcnt(0)
  s_mov_b64 s[40:41], s[16:17]
  s_mov_b64 exec, s[68:69]
  buffer_store_dword v2, v4, s[40:43], 0 offen
  s_mov_b64 exec, s[66:67]
  buffer_load_dword v2, v4, s[40:43], 0 offen sc1
  s_mov_b64 exec, -1
  s_barrier
  s_load_dword s74, s[8:9], s48
  s_mov_b32 s55, 16
L_c1:
  s_barrier
  s_add_u32 s55, s55, 4
  s_cmp_lt_u32 s55, 60
  s_cbranch_scc1 L_c1
  s_branch L_c2
L_c6:
  s_waitcnt lgkmcnt(0)
  s_endpgm
L_c2:
  s_barrier
  s_memrealtime s[18:19]
  s_add_u32 s55, s55, 4
  s_waitcnt vmcnt(16) lgkmcnt(0)
  s_add_u32 s52, s18, s51
  s_sub_u32 s18, 2048, s52
  v_add_u32 v3, s18, v2
  v_cmp_gt_u32 vcc, 4096, v3
  v_subrev_u32 v3, 2048, v3
  s_lshr_b32 s61, vcc_hi, 16
  v_cndmask_b32 v3, 0, v3, vcc
  s_sub_u32 s51, s51, 53
  v_readlane_b32 s58, v3, 32
  v_readlane_b32 s59, v3, 33
  v_readlane_b32 s60, v3, s54
  v_add_u32_dpp v3, v3, v3 row_ror:1 row_mask:0xf bank_mask:0xf
  s_sub_i32 s58, s58, s59
  s_cmpk_lt_u32 s55, 416
  v_add_u32_dpp v3, v3, v3 row_ror:2 row_mask:0xf bank_mask:0xf
  s_cselect_b32 s59, 48, 12
  s_cselect_b32 s74, 8, 64
  v_add_u32_dpp v3, v3, v3 row_ror:4 row_mask:0xf bank_mask:0xf
  s_sub_u32 s19, s55, 200
  s_cmpk_lt_u32 s19, 104
  s_cselect_b32 s59, 16, s59
  s_cselect_b32 s74, 32, s74
  s_mul_i32 s58, s58, s59
  s_add_i32 s58, s58, -64
  v_add_u32_dpp v3, v3, v3 row_ror:8 row_mask:0xf bank_mask:0xf
  s_cmpk_eq_u32 s61, 0xff
  v_readlane_b32 s18, v3, 0
  v_readlane_b32 s19, v3, 16
  v_readlane_b32 s59, v3, 48
  s_cselect_b32 s60, s60, 0
  s_cselect_b32 s59, s59, 0
  s_add_i32 s18, s18, s19
  s_sub_i32 s58, s58, s18
  s_mul_i32 s19, s74, s58
  s_ashr_i32 s19, s19, 8
  s_add_i32 s56, s56, s19
  s_mul_i32 s62, s56, 596
  s_ashr_i32 s62, s62, 16
  s_mul_i32 s63, s56, -513
  s_ashr_i32 s63, s63, 16
  s_max_i32 s62, s62, 0
  s_max_i32 s63, s63, 0
  s_mul_i32 s19, s62, 110
  s_sub_i32 s56, s56, s19
  s_mul_i32 s19, s63, 128
  s_add_i32 s56, s56, s19
  s_min_i32 s62, s62, 4
  s_min_i32 s63, s63, 3
  s_add_u32 s62, s62, s55
  s_add_u32 s63, s63, s55
  s_pack_ll_b32_b16 s62, s62, s63
  v_mov_b32 v8, s62
  ds_write_b32 v9, v8 offset:12
  s_bitcmp1_b32 s55, 2
  s_cbranch_scc1 L_c2
  s_cmpk_eq_u32 s55, 504
  s_cbranch_scc1 L_c6
  s_ashr_i32 s59, s59, 3
  s_add_u32 s59, s59, s52
  s_add_u32 s60, s60, s52
  s_ashr_i32 s18, s18, 5
  s_add_u32 s18, s18, s52
  v_mov_b32 v10, s52
  v_writelane_b32 v10, s60, 32
  v_writelane_b32 v10, s59, 33
  v_mov_b32 v7, s18
  s_lshr_b32 s19, s55, 3
  s_lshr_b64 s[78:79], s[80:81], s19
  s_mov_b64 exec, s[68:69]
  buffer_store_dword v10, v4, s[40:43], 0 offen
  s_mov_b64 exec, s[66:67]
  buffer_load_dword v2, v4, s[40:43], 0 offen sc1
  s_bitcmp0_b32 s78, 1
  s_cbranch_scc1 L_c4
  s_mov_b64 exec, s[72:73]
  buffer_atomic_swap v7, v4, s[40:43], 0 offen sc1
L_c4:
  s_bitcmp0_b32 s78, 0
  s_cbranch_scc1 L_c5
  s_mov_b64 exec, s[64:65]
  buffer_load_dword v2, v4, s[40:43], 0 offen sc1
L_c5:
  s_mov_b64 exec, -1
  s_branch L_c2
L_pro:
  s_bfm_b64 exec, 48, 0
  v_mov_b32 v12, v13
  s_bfm_b64 exec, 32, 0
  v_mov_b32 v13, 0
  s_bfm_b64 exec, 16, 0
  v_mov_b32 v12, 0
  v_mov_b32 v29, v60
  s_bfm_b64 exec, 8, 0
  v_mov_b32 v61, v60
  s_mov_b64 exec, -1
  v_writelane_b32 v56, 0, 0
  v_and_b32 v6, 7, v1
  v_lshlrev_b32 v6, 1, v6
  v_xor_b32 v6, v6, v5
  v_lshlrev_b32 v6, 4, v6
  v_lshl_add_u32 v16, v1, 9, v6
  v_xor_b32 v17, 64, v16
  v_xor_b32 v18, 128, v16
  v_xor_b32 v19, 192, v16
  v_lshlrev_b32 v11, 4, v5
  v_lshl_add_u32 v15, v5, 3, v59
  v_lshrrev_b32 v6, 2, v0
  v_and_b32 v7, 7, v6
  s_lshl_b32 s18, s66, 2
  v_xor_b32 v7, s18, v7
  v_lshlrev_b32 v7, 5, v7
  v_lshl_add_u32 v7, v6, 9, v7
  v_and_b32 v10, 3, v0
  v_lshl_add_u32 v20, v10, 3, v7
  v_xor_b32 v21, 32, v20
  v_xor_b32 v22, 64, v20
  v_xor_b32 v23, 96, v20
  s_mov_b32 s54, 0x100001
  s_mov_b32 s55, 0x10000100
  s_mov_b32 s56, 0x200002
  s_mov_b32 s57, 0x20000200
  s_mov_b32 s58, 0x400004
  s_mov_b32 s59, 0x40000400
  s_mov_b32 s60, 0x800008
  s_mov_b32 s61, 0x80000800
  s_mov_b32 s62, 0x3eb8aa3b
  v_mov_b32 v8, 0xbe000000
  v_mov_b32 v9, 0x358637bd
  v_mov_b32 v148, 0
  v_mov_b32 v149, 0
  v_mov_b32 v150, 0
  v_mov_b32 v151, 0
  v_mov_b32 v152, 0
  v_mov_b32 v153, 0
  v_mov_b32 v154, 0
  v_mov_b32 v155, 0
  v_mov_b32 v156, 0
  v_mov_b32 v157, 0
  v_mov_b32 v158, 0
  v_mov_b32 v159, 0
  v_mov_b32 v160, 0
  v_mov_b32 v161, 0
  v_mov_b32 v162, 0
  v_mov_b32 v163, 0
  v_mov_b32 v14, 0
  s_and_b32 s18, s66, 1
  s_lshr_b32 s52, s66, 1
  s_lshl_b32 s49, s52, 14
  s_lshl_b32 s53, s18, 13
  s_add_u32 s49, s49, s53
  s_lshl_b32 s53, s52, 8
  s_lshl_b32 s18, s18, 3
  s_add_u32 s53, s53, s18
  s_add_u32 s53, s53, 65536
  v_lshl_add_u32 v28, v6, 4, s53
  v_lshl_add_u32 v28, v10, 1, v28
  v_add_u32 v24, 81920, v16
  v_add_u32 v25, 81920, v17
  v_add_u32 v26, 81920, v18
  v_add_u32 v27, 81920, v19
  v_add_u32 v2, 90112, v11
  s_mov_b32 s50, 32
  s_cmp_eq_u32 s65, 0
  s_cselect_b32 s84, 25, 6
  s_branch L_back
L_phi:
  s_barrier
  ds_read_b128 v[64:67], v24 offset:0
  ds_read_b128 v[68:71], v25 offset:0
  ds_read_b128 v[72:75], v26 offset:0
  ds_read_b128 v[76:79], v27 offset:0
  ds_read_b128 v[80:83], v24 offset:256
  ds_read_b128 v[84:87], v25 offset:256
  ds_read_b128 v[88:91], v26 offset:256
  ds_read_b128 v[92:95], v27 offset:256
  v_add_u32 v24, s49, v16
  v_add_u32 v25, s49, v17
  v_add_u32 v26, s49, v18
  v_add_u32 v27, s49, v19
  ds_read_b128 v[96:99], v2 offset:0
  ds_read_b128 v[100:103], v2 offset:64
  ds_read_b128 v[104:107], v2 offset:128
  ds_read_b128 v[108:111], v2 offset:192
  ds_read_b128 v[112:115], v2 offset:256
  ds_read_b128 v[116:119], v2 offset:320
  ds_read_b128 v[120:123], v2 offset:384
  ds_read_b128 v[124:127], v2 offset:448
  s_waitcnt lgkmcnt(0)
  v_mfma_f32_16x16x32_bf16 v[32:35], v[64:67], v[96:99], 0
  v_mfma_f32_16x16x32_bf16 v[36:39], v[96:99], v[96:99], 0
  v_mfma_f32_16x16x32_bf16 v[32:35], v[68:71], v[100:103], v[32:35]
  v_mfma_f32_16x16x32_bf16 v[36:39], v[100:103], v[100:103], v[36:39]
  v_mfma_f32_16x16x32_bf16 v[32:35], v[72:75], v[104:107], v[32:35]
  v_mfma_f32_16x16x32_bf16 v[36:39], v[104:107], v[104:107], v[36:39]
  v_mfma_f32_16x16x32_bf16 v[32:35], v[76:79], v[108:111], v[32:35]
  v_mfma_f32_16x16x32_bf16 v[36:39], v[108:111], v[108:111], v[36:39]
  v_mfma_f32_16x16x32_bf16 v[32:35], v[80:83], v[112:115], v[32:35]
  v_mfma_f32_16x16x32_bf16 v[36:39], v[112:115], v[112:115], v[36:39]
  v_mfma_f32_16x16x32_bf16 v[32:35], v[84:87], v[116:119], v[32:35]
  v_mfma_f32_16x16x32_bf16 v[36:39], v[116:119], v[116:119], v[36:39]
  v_mfma_f32_16x16x32_bf16 v[32:35], v[88:91], v[120:123], v[32:35]
  v_mfma_f32_16x16x32_bf16 v[36:39], v[120:123], v[120:123], v[36:39]
  v_mfma_f32_16x16x32_bf16 v[32:35], v[92:95], v[124:127], v[32:35]
  v_mfma_f32_16x16x32_bf16 v[36:39], v[124:127], v[124:127], v[36:39]
  s_nop 7
  v_cvt_pk_bf16_f32 v42, v32, v33
  v_cvt_pk_bf16_f32 v43, v34, v35
  v_lshlrev_b32 v32, 16, v42
  v_and_b32 v33, 0xffff0000, v42
  v_lshlrev_b32 v34, 16, v43
  v_and_b32 v35, 0xffff0000, v43
  v_cvt_pk_bf16_f32 v40, v36, v36
  v_and_b32 v40, 0xffff0000, v40
  v_fma_f32 v44, v40, v8, v32
  v_fma_f32 v45, v40, v8, v33
  v_fma_f32 v46, v40, v8, v34
  v_fma_f32 v47, v40, v8, v35
  v_cvt_pk_bf16_f32 v42, v44, v45
  v_cvt_pk_bf16_f32 v43, v46, v47
  v_lshlrev_b32 v44, 16, v42
  v_and_b32 v45, 0xffff0000, v42
  v_lshlrev_b32 v46, 16, v43
  v_and_b32 v47, 0xffff0000, v43
  v_mul_f32 v44, s62, v44
  v_mul_f32 v45, s62, v45
  v_mul_f32 v46, s62, v46
  v_mul_f32 v47, s62, v47
  v_exp_f32 v44, v44
  v_exp_f32 v45, v45
  v_exp_f32 v46, v46
  v_exp_f32 v47, v47
  s_nop 0
  v_cvt_pk_bf16_f32 v42, v44, v45
  v_cvt_pk_bf16_f32 v43, v46, v47
  v_lshlrev_b32 v44, 16, v42
  v_and_b32 v45, 0xffff0000, v42
  v_lshlrev_b32 v46, 16, v43
  v_and_b32 v47, 0xffff0000, v43
  v_fmamk_f32 v44, v44, 0x3e800000, v9
  v_fmamk_f32 v45, v45, 0x3e800000, v9
  v_fmamk_f32 v46, v46, 0x3e800000, v9
  v_fmamk_f32 v47, v47, 0x3e800000, v9
  v_cvt_pk_bf16_f32 v48, v44, v45
  v_cvt_pk_bf16_f32 v49, v46, v47
  ds_write_b64 v15, v[48:49] offset:32
  s_waitcnt lgkmcnt(0)
  s_branch L_k
L_ke:
  s_cmp_eq_u32 s50, 23
  s_cbranch_scc1 L_ke3
  s_cmp_eq_u32 s50, 21
  s_cbranch_scc1 L_ke4
  s_cmp_eq_u32 s50, 6
  s_cbranch_scc1 L_ke5
  s_mov_b32 s84, 23
  s_waitcnt vmcnt(0)
  v_readlane_b32 s51, v137, 1
  s_getreg_b32 s18, hwreg(HW_REG_XCC_ID, 0, 4)
  s_add_u32 s51, s51, 1
  s_and_b32 s51, s51, 0xffffff
  s_bitset1_b32 s51, 31
  s_lshl_b32 s18, s18, 24
  s_or_b32 s51, s51, s18
  v_xor_b32 v3, s51, v128
  s_lshr_b32 s18, s51, 6
  v_bitop3_b32 v3, v129, v3, s18 bitop3:0xde
  s_lshr_b32 s18, s51, 12
  v_bitop3_b32 v3, v130, v3, s18 bitop3:0xde
  s_lshr_b32 s18, s51, 18
  v_bitop3_b32 v3, v131, v3, s18 bitop3:0xde
  v_and_b32 v3, 63, v3
  v_cmp_eq_u32 vcc, 0, v3
  v_xor_b32 v128, 1, v128
  s_cbranch_vccz L_kc0
  s_mov_b64 exec, vcc
  buffer_store_dword v128, v60, s[40:43], s67 offen offset:0 sc1
  s_mov_b64 exec, -1
L_kc0:
  v_xor_b32 v3, s51, v132
  s_lshr_b32 s18, s51, 6
  v_bitop3_b32 v3, v133, v3, s18 bitop3:0xde
  s_lshr_b32 s18, s51, 12
  v_bitop3_b32 v3, v134, v3, s18 bitop3:0xde
  s_lshr_b32 s18, s51, 18
  v_bitop3_b32 v3, v135, v3, s18 bitop3:0xde
  v_and_b32 v3, 63, v3
  v_cmp_eq_u32 vcc, 0, v3
  v_xor_b32 v132, 1, v132
  s_cbranch_vccz L_kc1
  s_mov_b64 exec, vcc
  buffer_store_dword v132, v60, s[40:43], s67 offen offset:1024 sc1
  s_mov_b64 exec, -1
L_kc1:
  v_cmp_eq_u32 vcc, s51, v137
  s_cbranch_vccz L_ke_ret
  s_mov_b64 exec, vcc
  buffer_store_dword v58, v54, s[40:43], s69 offen offset:1028 sc1
  s_mov_b64 exec, -1
  s_branch L_ke_ret
L_ke3:
  s_mov_b32 s84, 21
  s_waitcnt vmcnt(0)
  s_branch L_ke_ret
L_ke4:
  s_mov_b32 s84, 6
  s_cmp_lg_u32 s66, 0
  s_cbranch_scc1 L_ke_ret
  v_mov_b32 v5, s51
  buffer_atomic_swap v5, v56, s[44:47], s93 offen sc1
  s_branch L_ke_ret
L_ke5:
  s_cmp_lg_u32 s66, 0
  s_cbranch_scc1 L_ke_ret
  buffer_load_dword v30, v56, s[44:47], s93 offen
  s_branch L_ke_ret
L_ve:
  s_cmp_gt_u32 s50, 3
  s_cbranch_scc1 L_ve_0
  s_sub_u32 s84, s84, 1
  s_cmp_eq_u32 s50, 2
  s_cbranch_scc1 L_ve_t4
  ds_read_b64 v[30:31], v59
L_ve_ret:
  s_waitcnt lgkmcnt(0)
  s_branch L_v
L_ve_t4:
  v_readfirstlane_b32 s20, v30
  s_getreg_b32 s18, hwreg(HW_REG_XCC_ID, 0, 4)
  s_mov_b32 s53, 1048576
  s_bfe_u32 s28, s20, 0x40018
  s_xor_b32 s28, s28, s18
  s_lshr_b32 s21, s20, 6
  s_lshr_b32 s22, s20, 12
  s_lshr_b32 s23, s20, 18
  s_cmp_eq_u32 s65, 0
  s_cselect_b32 s28, 1, s28
  s_cselect_b64 s[26:27], -1, 0
  s_lshl_b64 s[24:25], s[26:27], 16
  s_cbranch_scc0 L_v
  s_mov_b64 exec, s[24:25]
  buffer_load_dwordx4 v[64:67], v60, s[40:43], s67 offen sc1
  s_mov_b64 exec, -1
  buffer_load_dwordx4 v[68:71], v60, s[40:43], s67 offen offset:1024 sc1
  s_branch L_v
L_ve_0:
  s_cmp_eq_u32 s50, 62
  s_cbranch_scc1 L_ve_q
  s_cmp_eq_u32 s50, 56
  s_cbranch_scc0 L_ve_d
  s_mov_b32 s84, 53
  buffer_load_dwordx2 v[4:5], v54, s[40:43], s69 offen offset:1024 sc1 nt
  s_branch L_ve_ret
L_ve_d:
  s_mov_b32 s84, 3
  s_mov_b32 s53, 1048576
L_dn:
  s_waitcnt vmcnt(0)
  v_cmp_ne_u32 vcc, s51, v5
  v_cndmask_b32 v6, v4, v14, s[94:95]
  s_andn2_b64 vcc, vcc, s[94:95]
  s_cbranch_scc0 L_dn_ok
  buffer_load_dwordx2 v[4:5], v54, s[40:43], s69 offen offset:1024 sc1
  s_sub_u32 s53, s53, 1
  s_cbranch_scc0 L_dn
  s_waitcnt vmcnt(0)
  v_mov_b32 v6, -1
  s_nop 1
L_dn_ok:
  v_add_f32_dpp v6, v6, v6 quad_perm:[1,0,3,2] row_mask:0xf bank_mask:0xf
  s_nop 1
  v_add_f32_dpp v6, v6, v6 quad_perm:[2,3,0,1] row_mask:0xf bank_mask:0xf
  s_nop 1
  v_add_f32_dpp v6, v6, v6 row_half_mirror row_mask:0xf bank_mask:0xf
  v_cvt_pk_bf16_f32 v6, v6, v6
  v_and_b32 v6, 0xffff0000, v6
  v_add_f32 v6, v6, v9
  v_cvt_pk_bf16_f32 v6, v6, v6
  v_and_b32 v6, 0xffff0000, v6
  v_rcp_f32 v7, v6
  s_nop 0
  ds_write_b32 v59, v7 offset:4
  s_branch L_ve_ret
L_ve_q:
  v_add_u32 v2, v57, v59
  ds_read_b32 v14, v2 offset:256
  s_mov_b32 s53, 1048576
L_ep:
  s_waitcnt vmcnt(0)
  v_readfirstlane_b32 s51, v30
  s_cmp_lg_u32 s51, 0
  s_cbranch_scc1 L_ep_ok
  buffer_load_dword v30, v56, s[44:47], s93 offen sc1
  s_sub_u32 s53, s53, 1
  s_cbranch_scc0 L_ep
  s_waitcnt vmcnt(0)
L_ep_ok:
  v_mov_b32 v5, s51
  v_mov_b32 v6, 0
  v_mov_b32 v7, 0
  ds_write_b32 v59, v5
  s_cmp_eq_u32 s65, 0
  s_cselect_b32 s84, 56, 3
  s_getreg_b32 s18, hwreg(HW_REG_XCC_ID, 0, 4)
  s_bfe_u32 s85, s51, 0x40018
  s_waitcnt lgkmcnt(0)
  v_add_f32_dpp v14, v14, v14 row_ror:1 row_mask:0xf bank_mask:0xf
  s_nop 1
  v_add_f32_dpp v14, v14, v14 row_ror:2 row_mask:0xf bank_mask:0xf
  s_nop 1
  v_add_f32_dpp v14, v14, v14 row_ror:4 row_mask:0xf bank_mask:0xf
  s_nop 1
  v_add_f32_dpp v14, v14, v14 row_ror:8 row_mask:0xf bank_mask:0xf
  s_nop 1
  v_mov_b32 v2, v14
  s_nop 1
  v_permlane32_swap_b32 v2, v14
  v_add_f32 v14, v14, v2
  v_mov_b32 v2, v14
  s_nop 1
  v_permlane16_swap_b32 v2, v14
  v_add_f32 v14, v14, v2
  s_cmp_eq_u32 s65, 0
  s_cbranch_scc1 L_ve_ret
  v_mov_b32 v4, v14
  s_cmp_lg_u32 s85, s18
  s_cbranch_scc1 L_dfar
  buffer_store_dwordx4 v[4:7], v61, s[40:43], s63 offen offset:1024
  s_branch L_ve_ret
L_dfar:
  buffer_store_dwordx4 v[4:7], v61, s[40:43], s63 offen offset:1024 sc1
  s_branch L_ve_ret
L_end:
  s_endpgm
.section .rodata,"a"
.p2align 6
.amdhsa_kernel standalone__linear_kernel_rfa__decode_kernel
  .amdhsa_next_free_vgpr 164
  .amdhsa_next_free_sgpr 100
  .amdhsa_accum_offset 164
  .amdhsa_group_segment_fixed_size 0
  .amdhsa_kernarg_size 56
  .amdhsa_user_sgpr_count 2
  .amdhsa_user_sgpr_kernarg_segment_ptr 1
  .amdhsa_system_sgpr_workgroup_id_x 1
  .amdhsa_float_denorm_mode_32 3
.end_amdhsa_kernel
```
